```python
import torch

def _softmax(x, axis=-1):
    return torch.softmax(x, dim=axis)
def _gelu(x):
    return torch.nn.functional.gelu(x, approximate="tanh")
def _silu(x):
    return torch.nn.functional.silu(x)
def _sigmoid(x):
    return torch.sigmoid(x)
def _layernorm(x, axis=-1, eps=1e-5):
    m = x.mean(dim=axis, keepdim=True)
    v = x.var(dim=axis, keepdim=True, unbiased=False)
    return (x - m) / torch.sqrt(v + eps)
def _scatter_add(tgt, idx, src, axis=0):
    return tgt.clone().index_add_(axis, idx, src)
def _segment_sum(src, seg, n):
    out = torch.zeros((n,) + src.shape[1:], dtype=src.dtype)
    return out.index_add_(0, seg, src)
def _pad(x, pw):
    flat = tuple(v for pair in reversed(pw) for v in pair)
    return torch.nn.functional.pad(x, flat)

kernel_name = 'standalone__linear_kernel_rfa__prompt'

def setup_inputs():

    _w = (lambda a: (lambda t: t.to(torch.bfloat16) if t.is_floating_point() else t)(torch.as_tensor(a)))
    B, H, Sq, Sk, D, M = 1, 32, 2048, 2048, 128, 64
    return {
        "q": _w((lambda *s: torch.randn(*s, dtype=torch.bfloat16) * 0.05)(B, H, Sq, D)),
        "k": _w((lambda *s: torch.randn(*s, dtype=torch.bfloat16) * 0.8)(B, H, Sk, D)),
        "v": _w((lambda *s: torch.randn(*s, dtype=torch.bfloat16) * 0.8)(B, H, Sk, D)),
        "omega": _w((lambda *s: torch.randn(*s, dtype=torch.bfloat16) * 0.8)(M, D)),
    }

def reference(q, k, v, omega):
    d = q.shape[-1]
    m = omega.shape[0]
    scale = float(d) ** -0.25
    qs = q * scale
    ks = k * scale
    q_proj = torch.einsum("bhsd,md->bhsm", qs, omega)
    k_proj = torch.einsum("bhsd,md->bhsm", ks, omega)
    q_sq = 0.5 * torch.einsum("bhsd,bhsd->bhs", qs, qs)[..., None]
    k_sq = 0.5 * torch.einsum("bhsd,bhsd->bhs", ks, ks)[..., None]
    inv_sqrt_m = float(m) ** -0.5
    phi_q = torch.exp(q_proj - q_sq) * inv_sqrt_m + 1e-6
    phi_k = torch.exp(k_proj - k_sq) * inv_sqrt_m + 1e-6
    kv = torch.einsum("bhsm,bhsd->bhmd", phi_k, v)
    z  = torch.einsum("bhsm->bhm", phi_k)
    num = torch.einsum("bhqm,bhmd->bhqd", phi_q, kv)
    den = torch.einsum("bhqm,bhm->bhq", phi_q, z)[..., None] + 1e-6
    return num / den
```

```asm
; @launch grid=(256,1,1) block=(768,1,1) lds=150528
.amdgcn_target "amdgcn-amd-amdhsa--gfx950"
.text
.globl standalone__linear_kernel_rfa__prompt_kernel
.p2align 8
.type standalone__linear_kernel_rfa__prompt_kernel,@function
standalone__linear_kernel_rfa__prompt_kernel:
    s_cmp_ge_u32 s2, 256
    s_cbranch_scc1 L_end
    s_load_dwordx4 s[4:7], s[0:1], 0
    s_load_dwordx4 s[8:11], s[0:1], 16
    s_load_dwordx2 s[12:13], s[0:1], 32
    s_load_dwordx2 s[16:17], s[0:1], 48
    s_getpc_b64 s[18:19]
    v_lshrrev_b32 v1, 6, v0
    v_and_b32 v0, 63, v0
    v_readfirstlane_b32 s49, v1
    v_and_b32 v72, 15, v0
    v_lshrrev_b32 v73, 4, v0
    s_and_b32 s52, s2, 7
    s_lshr_b32 s53, s2, 3
    s_and_b32 s51, s53, 7
    s_xor_b32 s54, s49, s53
    s_and_b32 s54, s54, 3
    s_cbranch_scc1 L_nopf
    s_lshl_b32 s54, s49, 10
    v_lshlrev_b32 v3, 4, v0
    v_add_u32 v3, s54, v3
    global_load_dwordx4 v[160:163], v3, s[18:19]
L_nopf:
    s_lshr_b32 s53, s53, 3
    s_lshl_b32 s52, s52, 2
    s_add_u32 s50, s53, s52
    s_lshl_b32 s64, s50, 3
    s_add_u32 s64, s64, s51
    s_lshl_b32 s48, s64, 16
    s_mov_b32 s22, 0x1000000
    s_mov_b32 s23, 0x00020000
    s_mov_b32 s26, 0x1000000
    s_mov_b32 s27, 0x00020000
    s_mov_b32 s30, 0x1000000
    s_mov_b32 s31, 0x00020000
    s_mov_b32 s34, 0x4000
    s_mov_b32 s35, 0x00020000
    s_mov_b32 s38, 0x1000000
    s_mov_b32 s39, 0x00020000
    s_mov_b32 s46, 0x10000000
    s_mov_b32 s47, 0x00020000
    s_cmp_ge_u32 s49, 4
    s_cbranch_scc1 L_kq
    s_setprio 2
    s_mov_b32 s65, s49
    s_lshl_b32 s67, s50, 2
    s_add_u32 s67, s67, s65
    s_lshl_b32 s55, s67, 12
    s_lshl_b32 s67, s67, 8
    s_add_u32 s67, s67, 16777216
    s_mul_i32 s90, s64, 65536
    s_mul_i32 s53, s65, 4224
    s_add_u32 s90, s90, s53
    s_lshl_b32 s54, s51, 9
    v_mov_b32 v88, -1
    v_mov_b32 v89, -1
    v_mov_b32 v90, -1
    v_mov_b32 v91, -1
    v_lshlrev_b32 v2, 4, v0
    v_lshlrev_b32 v6, 2, v72
    v_add_u32 v167, 4096, v6
    v_lshrrev_b32 v11, 5, v0
    v_and_b32 v12, 31, v0
    v_lshlrev_b32 v12, 4, v12
    v_lshl_add_u32 v106, v11, 3, v12
    v_add_u32 v76, 0, v73
    v_add_u32 v77, 4, v73
    v_add_u32 v78, 8, v73
    v_add_u32 v79, 12, v73
    v_xor_b32 v76, v76, v72
    v_xor_b32 v77, v77, v72
    v_xor_b32 v78, v78, v72
    v_xor_b32 v79, v79, v72
    v_lshlrev_b32 v76, 4, v76
    v_lshlrev_b32 v77, 4, v77
    v_lshlrev_b32 v78, 4, v78
    v_lshlrev_b32 v79, 4, v79
    v_lshl_add_u32 v76, v73, 8, v76
    v_lshl_add_u32 v77, v73, 8, v77
    v_lshl_add_u32 v78, v73, 8, v78
    v_lshl_add_u32 v79, v73, 8, v79
    s_waitcnt lgkmcnt(0)
    s_mov_b64 s[44:45], s[16:17]
    s_mov_b64 s[28:29], s[8:9]
    s_mov_b64 s[32:33], s[10:11]
    s_mov_b64 s[20:21], s[12:13]
    s_add_u32 s9, s55, 17301504
    s_add_u32 s10, s9, s54
    s_lshl_b32 s52, s65, 12
    s_mov_b32 m0, s52
    s_nop 0
    buffer_load_dwordx4 v76, s[32:35], s52 offen offset:0  lds
    buffer_load_dwordx4 v77, s[32:35], s52 offen offset:1024  lds
    buffer_load_dwordx4 v78, s[32:35], s52 offen offset:2048  lds
    buffer_load_dwordx4 v79, s[32:35], s52 offen offset:3072  lds
    buffer_load_dword v8, off, s[44:47], s67 offset:128 sc1
    v_mul_u32_u24 v104, 65536, v11
    v_add_u32 v104, v104, v12
    v_lshrrev_b32 v9, 3, v0
    v_and_b32 v14, 7, v0
    v_lshlrev_b32 v15, 3, v14
    v_mul_u32_u24 v105, 65536, v9
    v_add_u32 v105, v105, v15
    v_add_u32 v105, 4096, v105
    s_mul_i32 s8, s50, 524288
    s_add_u32 s8, s8, s53
    s_add_u32 s4, s8, s54
    s_add_u32 s5, s4, 131072
    s_add_u32 s6, s4, 262144
    s_add_u32 s7, s4, 393216
    s_lshl_b32 s11, s51, 3
    s_add_u32 s11, s11, s67
    v_lshlrev_b32 v9, 2, v73
    v_xor_b32 v9, v9, v72
    v_lshlrev_b32 v9, 4, v9
    v_lshl_add_u32 v1, v73, 8, v9
    v_and_b32 v10, 3, v0
    s_lshl_b32 s52, s65, 11
    s_add_u32 s66, s52, 84992
    s_add_u32 s12, s52, s48
    v_mov_b32 v108, 18944
    s_lshl_b32 s52, s65, 2
    v_add_u32 v109, s52, v108
    v_mov_b32 v9, 0
    ds_write_b32 v109, v9
    v_bfe_u32 v12, v0, 3, 1
    v_bfe_u32 v13, v0, 4, 1
    v_lshlrev_b32 v3, 10, v11
    v_lshl_add_u32 v3, v12, 8, v3
    v_lshl_add_u32 v3, v13, 7, v3
    v_lshl_add_u32 v3, v14, 4, v3
    v_add_u32 v3, 23552, v3
    v_bfe_u32 v9, v0, 2, 2
    v_lshlrev_b32 v4, 10, v11
    v_lshl_add_u32 v4, v9, 8, v4
    v_xor_b32 v9, s65, v9
    v_lshl_add_u32 v4, v9, 6, v4
    v_lshl_add_u32 v4, v13, 5, v4
    v_lshl_add_u32 v4, v10, 3, v4
    v_add_u32 v4, 84992, v4
    s_lshr_b32 s52, s65, 1
    s_lshl_b32 s52, s52, 6
    s_and_b32 s53, s65, 1
    s_lshl_b32 s53, s53, 3
    s_add_u32 s52, s52, s53
    s_add_u32 s52, s52, 16640
    v_bfe_u32 v9, v0, 1, 2
    v_and_b32 v10, 1, v0
    v_lshlrev_b32 v7, 4, v9
    v_lshl_add_u32 v7, v10, 2, v7
    v_lshl_add_u32 v7, v13, 1, v7
    v_add_u32 v7, s52, v7
    v_mul_u32_u24 v5, 1040, v14
    v_lshl_add_u32 v5, v11, 8, v5
    v_bfe_u32 v9, v0, 3, 2
    v_lshl_add_u32 v5, v9, 4, v5
    s_lshl_b32 s52, s65, 6
    v_add_u32 v5, s52, v5
    s_add_u32 s53, s52, 16896
    v_add_u32 v12, s53, v6
    s_mov_b32 s60, 0x00003f80
    s_mov_b32 s61, 0x3f800000
    s_getreg_b32 s54, hwreg(HW_REG_XCC_ID, 0, 4)
    s_waitcnt vmcnt(1)
    s_waitcnt lgkmcnt(0)
    s_branch L_v2
L_kq:
    s_sub_u32 s49, s49, 4
    s_setprio 1
    v_add_u32 v76, 0, v73
    v_add_u32 v77, 4, v73
    v_add_u32 v78, 8, v73
    v_add_u32 v79, 12, v73
    v_xor_b32 v76, v76, v72
    v_xor_b32 v77, v77, v72
    v_xor_b32 v78, v78, v72
    v_xor_b32 v79, v79, v72
    v_lshlrev_b32 v76, 4, v76
    v_lshlrev_b32 v77, 4, v77
    v_lshlrev_b32 v78, 4, v78
    v_lshlrev_b32 v79, 4, v79
    v_lshl_add_u32 v1, v73, 8, v76
    v_lshl_add_u32 v2, v73, 8, v77
    v_lshl_add_u32 v3, v73, 8, v78
    v_lshl_add_u32 v4, v73, 8, v79
    s_lshl_b32 s55, s49, 13
    s_add_u32 s65, s48, s55
    s_add_u32 s66, s65, 4096
    s_add_u32 s67, s55, 19456
    s_add_u32 s54, s67, 4096
    s_waitcnt lgkmcnt(0)
    s_mov_b64 s[32:33], s[10:11]
    s_mov_b64 s[24:25], s[6:7]
    s_mov_b64 s[20:21], s[4:5]
    s_mov_b64 s[36:37], s[12:13]
    s_mov_b64 s[44:45], s[16:17]
    s_mov_b32 m0, s67
    s_nop 0
    buffer_load_dwordx4 v1, s[24:27], s65 offen offset:0 nt lds
    buffer_load_dwordx4 v2, s[24:27], s65 offen offset:1024 nt lds
    buffer_load_dwordx4 v3, s[24:27], s65 offen offset:2048 nt lds
    buffer_load_dwordx4 v4, s[24:27], s65 offen offset:3072 nt lds
    s_mov_b32 m0, s54
    s_nop 0
    buffer_load_dwordx4 v1, s[24:27], s66 offen offset:0 nt lds
    buffer_load_dwordx4 v2, s[24:27], s66 offen offset:1024 nt lds
    buffer_load_dwordx4 v3, s[24:27], s66 offen offset:2048 nt lds
    buffer_load_dwordx4 v4, s[24:27], s66 offen offset:3072 nt lds
    s_setprio 0
    v_lshl_add_u32 v80, v72, 8, v76
    v_lshl_add_u32 v81, v72, 8, v77
    v_lshl_add_u32 v82, v72, 8, v78
    v_lshl_add_u32 v83, v72, 8, v79
    v_add_u32 v5, s67, v80
    v_add_u32 v6, s67, v81
    v_add_u32 v7, s67, v82
    v_add_u32 v8, s67, v83
    s_mov_b32 s56, 0x3edb9ada
    s_mov_b32 s57, 0x3edb9ada
    s_mov_b32 s58, 0x358637bd
    s_mov_b32 s59, 0x358637bd
    v_lshlrev_b32 v11, 10, v73
    v_lshl_add_u32 v11, v72, 4, v11
    v_add_u32 v9, s54, v11
    s_lshl_b32 s52, s49, 8
    s_add_u32 s52, s52, 16896
    v_lshlrev_b32 v10, 4, v73
    v_add_u32 v12, 16640, v10
    v_add_u32 v10, s52, v10
    v_lshlrev_b32 v15, 4, v0
    v_mov_b32 v13, 0xbd8293ee
    v_mov_b32 v14, 0xbf400000
    v_mov_b32 v20, 0x3f803f80
    v_mov_b32 v21, 0x3f803f80
    v_mov_b32 v22, 0x3f803f80
    v_mov_b32 v23, 0x3f803f80
    v_mov_b32 v25, 0
    v_mov_b32 v26, 0
    v_mov_b32 v27, 0
    v_mov_b32 v29, 0
    v_mov_b32 v30, 0
    v_mov_b32 v31, 0
    s_waitcnt vmcnt(8)
    s_barrier
    ds_read_b128 v[104:107], v80 offset:0
    ds_read_b128 v[120:123], v80 offset:4096
    ds_read_b128 v[136:139], v80 offset:8192
    ds_read_b128 v[152:155], v80 offset:12288
    ds_read_b128 v[108:111], v81 offset:0
    ds_read_b128 v[124:127], v81 offset:4096
    ds_read_b128 v[140:143], v81 offset:8192
    ds_read_b128 v[156:159], v81 offset:12288
    ds_read_b128 v[112:115], v82 offset:0
    ds_read_b128 v[128:131], v82 offset:4096
    ds_read_b128 v[144:147], v82 offset:8192
    ds_read_b128 v[160:163], v82 offset:12288
    ds_read_b128 v[116:119], v83 offset:0
    ds_read_b128 v[132:135], v83 offset:4096
    ds_read_b128 v[148:151], v83 offset:8192
    ds_read_b128 v[164:167], v83 offset:12288
    s_waitcnt vmcnt(4)
    ds_read_b128 v[40:43], v5 offset:0
    ds_read_b128 v[44:47], v6 offset:0
    ds_read_b128 v[48:51], v7 offset:0
    ds_read_b128 v[52:55], v8 offset:0
    s_waitcnt lgkmcnt(0)
    v_mfma_f32_16x16x32_bf16 v[72:75], v[40:43], v[104:107], 0
    v_dot2_f32_bf16 v16, v40, v40, 0
    v_mfma_f32_16x16x32_bf16 v[80:83], v[40:43], v[120:123], 0
    v_dot2_f32_bf16 v16, v41, v41, v16
    v_mfma_f32_16x16x32_bf16 v[88:91], v[40:43], v[136:139], 0
    v_dot2_f32_bf16 v16, v42, v42, v16
    v_mfma_f32_16x16x32_bf16 v[96:99], v[40:43], v[152:155], 0
    v_dot2_f32_bf16 v16, v43, v43, v16
    v_mfma_f32_16x16x32_bf16 v[72:75], v[44:47], v[108:111], v[72:75]
    v_dot2_f32_bf16 v16, v44, v44, v16
    v_mfma_f32_16x16x32_bf16 v[80:83], v[44:47], v[124:127], v[80:83]
    v_dot2_f32_bf16 v16, v45, v45, v16
    v_mfma_f32_16x16x32_bf16 v[88:91], v[44:47], v[140:143], v[88:91]
    v_dot2_f32_bf16 v16, v46, v46, v16
    v_mfma_f32_16x16x32_bf16 v[96:99], v[44:47], v[156:159], v[96:99]
    v_dot2_f32_bf16 v16, v47, v47, v16
    v_mfma_f32_16x16x32_bf16 v[72:75], v[48:51], v[112:115], v[72:75]
    v_dot2_f32_bf16 v16, v48, v48, v16
    v_mfma_f32_16x16x32_bf16 v[80:83], v[48:51], v[128:131], v[80:83]
    v_dot2_f32_bf16 v16, v49, v49, v16
    v_mfma_f32_16x16x32_bf16 v[88:91], v[48:51], v[144:147], v[88:91]
    v_dot2_f32_bf16 v16, v50, v50, v16
    v_mfma_f32_16x16x32_bf16 v[96:99], v[48:51], v[160:163], v[96:99]
    v_dot2_f32_bf16 v16, v51, v51, v16
    v_mfma_f32_16x16x32_bf16 v[72:75], v[52:55], v[116:119], v[72:75]
    v_dot2_f32_bf16 v16, v52, v52, v16
    v_mfma_f32_16x16x32_bf16 v[80:83], v[52:55], v[132:135], v[80:83]
    v_dot2_f32_bf16 v16, v53, v53, v16
    v_mfma_f32_16x16x32_bf16 v[88:91], v[52:55], v[148:151], v[88:91]
    v_dot2_f32_bf16 v16, v54, v54, v16
    v_mfma_f32_16x16x32_bf16 v[96:99], v[52:55], v[164:167], v[96:99]
    v_dot2_f32_bf16 v16, v55, v55, v16
    s_nop 2
    v_fma_f32 v16, v16, v13, v14
    v_cvt_pk_bf16_f32 v18, 0, v16
    v_sub_f32 v18, v16, v18
    v_cvt_pk_bf16_f32 v24, v16, v18
    s_waitcnt vmcnt(0)
    ds_read_b128 v[56:59], v5 offset:4096
    ds_read_b128 v[60:63], v6 offset:4096
    ds_read_b128 v[64:67], v7 offset:4096
    ds_read_b128 v[68:71], v8 offset:4096
    v_mfma_f32_16x16x32_bf16 v[32:35], v[24:27], v[20:23], 0
    s_nop 7
    v_pk_fma_f32 v[72:73], v[72:73], s[56:57], v[32:33]
    v_pk_fma_f32 v[74:75], v[74:75], s[56:57], v[34:35]
    v_pk_fma_f32 v[80:81], v[80:81], s[56:57], v[32:33]
    v_pk_fma_f32 v[82:83], v[82:83], s[56:57], v[34:35]
    v_exp_f32 v72, v72
    v_exp_f32 v73, v73
    v_exp_f32 v74, v74
    v_exp_f32 v75, v75
    v_exp_f32 v80, v80
    v_exp_f32 v81, v81
    v_exp_f32 v82, v82
    v_exp_f32 v83, v83
    v_pk_add_f32 v[72:73], v[72:73], s[58:59]
    v_pk_add_f32 v[74:75], v[74:75], s[58:59]
    v_pk_add_f32 v[80:81], v[80:81], s[58:59]
    v_pk_add_f32 v[82:83], v[82:83], s[58:59]
    v_cvt_pk_bf16_f32 v72, v72, v73
    v_cvt_pk_bf16_f32 v73, v74, v75
    v_cvt_pk_bf16_f32 v80, v80, v81
    v_cvt_pk_bf16_f32 v81, v82, v83
    s_waitcnt lgkmcnt(0)
    v_mfma_f32_16x16x32_bf16 v[76:79], v[56:59], v[104:107], 0
    v_dot2_f32_bf16 v17, v56, v56, 0
    v_dot2_f32_bf16 v17, v57, v57, v17
    v_dot2_f32_bf16 v17, v58, v58, v17
    v_mfma_f32_16x16x32_bf16 v[84:87], v[56:59], v[120:123], 0
    v_dot2_f32_bf16 v17, v59, v59, v17
    v_dot2_f32_bf16 v17, v60, v60, v17
    v_dot2_f32_bf16 v17, v61, v61, v17
    v_mfma_f32_16x16x32_bf16 v[92:95], v[56:59], v[136:139], 0
    v_dot2_f32_bf16 v17, v62, v62, v17
    v_dot2_f32_bf16 v17, v63, v63, v17
    v_dot2_f32_bf16 v17, v64, v64, v17
    v_mfma_f32_16x16x32_bf16 v[100:103], v[56:59], v[152:155], 0
    v_dot2_f32_bf16 v17, v65, v65, v17
    v_dot2_f32_bf16 v17, v66, v66, v17
    v_dot2_f32_bf16 v17, v67, v67, v17
    v_mfma_f32_16x16x32_bf16 v[76:79], v[60:63], v[108:111], v[76:79]
    v_dot2_f32_bf16 v17, v68, v68, v17
    v_dot2_f32_bf16 v17, v69, v69, v17
    v_dot2_f32_bf16 v17, v70, v70, v17
    v_mfma_f32_16x16x32_bf16 v[84:87], v[60:63], v[124:127], v[84:87]
    v_dot2_f32_bf16 v17, v71, v71, v17
    s_nop 2
    v_fma_f32 v17, v17, v13, v14
    v_cvt_pk_bf16_f32 v18, 0, v17
    v_mfma_f32_16x16x32_bf16 v[92:95], v[60:63], v[140:143], v[92:95]
    v_sub_f32 v18, v17, v18
    v_cvt_pk_bf16_f32 v28, v17, v18
    s_nop 1
    v_mfma_f32_16x16x32_bf16 v[36:39], v[28:31], v[20:23], 0
    v_mfma_f32_16x16x32_bf16 v[100:103], v[60:63], v[156:159], v[100:103]
    v_pk_fma_f32 v[88:89], v[88:89], s[56:57], v[32:33]
    v_pk_fma_f32 v[90:91], v[90:91], s[56:57], v[34:35]
    v_pk_fma_f32 v[96:97], v[96:97], s[56:57], v[32:33]
    v_mfma_f32_16x16x32_bf16 v[76:79], v[64:67], v[112:115], v[76:79]
    v_pk_fma_f32 v[98:99], v[98:99], s[56:57], v[34:35]
    v_exp_f32 v88, v88
    v_exp_f32 v89, v89
    v_mfma_f32_16x16x32_bf16 v[84:87], v[64:67], v[128:131], v[84:87]
    v_exp_f32 v90, v90
    v_exp_f32 v91, v91
    v_exp_f32 v96, v96
    v_mfma_f32_16x16x32_bf16 v[92:95], v[64:67], v[144:147], v[92:95]
    v_exp_f32 v97, v97
    v_exp_f32 v98, v98
    v_exp_f32 v99, v99
    v_mfma_f32_16x16x32_bf16 v[100:103], v[64:67], v[160:163], v[100:103]
    v_pk_add_f32 v[88:89], v[88:89], s[58:59]
    v_pk_add_f32 v[90:91], v[90:91], s[58:59]
    v_pk_add_f32 v[96:97], v[96:97], s[58:59]
    v_mfma_f32_16x16x32_bf16 v[76:79], v[68:71], v[116:119], v[76:79]
    v_pk_add_f32 v[98:99], v[98:99], s[58:59]
    v_cvt_pk_bf16_f32 v88, v88, v89
    v_cvt_pk_bf16_f32 v89, v90, v91
    v_mfma_f32_16x16x32_bf16 v[84:87], v[68:71], v[132:135], v[84:87]
    v_cvt_pk_bf16_f32 v96, v96, v97
    v_cvt_pk_bf16_f32 v97, v98, v99
    v_mfma_f32_16x16x32_bf16 v[92:95], v[68:71], v[148:151], v[92:95]
    v_mfma_f32_16x16x32_bf16 v[100:103], v[68:71], v[164:167], v[100:103]
    v_pk_fma_f32 v[76:77], v[76:77], s[56:57], v[36:37]
    v_pk_fma_f32 v[78:79], v[78:79], s[56:57], v[38:39]
    s_nop 1
    v_pk_fma_f32 v[84:85], v[84:85], s[56:57], v[36:37]
    v_pk_fma_f32 v[86:87], v[86:87], s[56:57], v[38:39]
    v_exp_f32 v76, v76
    v_exp_f32 v77, v77
    v_exp_f32 v78, v78
    v_exp_f32 v79, v79
    v_exp_f32 v84, v84
    v_exp_f32 v85, v85
    v_exp_f32 v86, v86
    v_exp_f32 v87, v87
    v_pk_add_f32 v[76:77], v[76:77], s[58:59]
    v_pk_add_f32 v[78:79], v[78:79], s[58:59]
    v_pk_add_f32 v[84:85], v[84:85], s[58:59]
    v_pk_add_f32 v[86:87], v[86:87], s[58:59]
    v_cvt_pk_bf16_f32 v74, v76, v77
    v_cvt_pk_bf16_f32 v75, v78, v79
    v_cvt_pk_bf16_f32 v82, v84, v85
    v_cvt_pk_bf16_f32 v83, v86, v87
    v_pk_fma_f32 v[92:93], v[92:93], s[56:57], v[36:37]
    v_pk_fma_f32 v[94:95], v[94:95], s[56:57], v[38:39]
    v_pk_fma_f32 v[100:101], v[100:101], s[56:57], v[36:37]
    v_pk_fma_f32 v[102:103], v[102:103], s[56:57], v[38:39]
    v_exp_f32 v92, v92
    v_exp_f32 v93, v93
    v_exp_f32 v94, v94
    v_exp_f32 v95, v95
    v_exp_f32 v100, v100
    v_exp_f32 v101, v101
    v_exp_f32 v102, v102
    v_exp_f32 v103, v103
    v_pk_add_f32 v[92:93], v[92:93], s[58:59]
    v_pk_add_f32 v[94:95], v[94:95], s[58:59]
    v_pk_add_f32 v[100:101], v[100:101], s[58:59]
    v_pk_add_f32 v[102:103], v[102:103], s[58:59]
    v_cvt_pk_bf16_f32 v90, v92, v93
    v_cvt_pk_bf16_f32 v91, v94, v95
    v_cvt_pk_bf16_f32 v98, v100, v101
    v_cvt_pk_bf16_f32 v99, v102, v103
    ds_write_b128 v9, v[72:75] offset:0
    v_mfma_f32_16x16x32_bf16 v[76:79], v[72:75], v[20:23], 0
    ds_write_b128 v9, v[80:83] offset:256
    v_mfma_f32_16x16x32_bf16 v[84:87], v[80:83], v[20:23], 0
    ds_write_b128 v9, v[88:91] offset:512
    v_mfma_f32_16x16x32_bf16 v[92:95], v[88:91], v[20:23], 0
    ds_write_b128 v9, v[96:99] offset:768
    v_mfma_f32_16x16x32_bf16 v[100:103], v[96:99], v[20:23], 0
    s_mov_b32 exec_lo, 0x00010001
    s_mov_b32 exec_hi, 0x00010001
    ds_write_b128 v10, v[76:79] offset:0
    s_nop 0
    ds_write_b128 v10, v[84:87] offset:64
    s_nop 0
    ds_write_b128 v10, v[92:95] offset:128
    s_nop 0
    ds_write_b128 v10, v[100:103] offset:192
    s_mov_b64 exec, -1
    s_waitcnt lgkmcnt(0)
    s_barrier
    s_cmp_ge_u32 s49, 4
    s_cbranch_scc1 L_q0a
    s_mov_b32 m0, s67
    s_nop 0
    buffer_load_dwordx4 v1, s[20:23], s65 offen offset:0 nt lds
    buffer_load_dwordx4 v2, s[20:23], s65 offen offset:1024 nt lds
    buffer_load_dwordx4 v3, s[20:23], s65 offen offset:2048 nt lds
    buffer_load_dwordx4 v4, s[20:23], s65 offen offset:3072 nt lds
L_q0a:
    s_barrier
    s_cmp_lt_u32 s49, 4
    s_cbranch_scc1 L_q0b
    s_mov_b32 m0, s67
    s_nop 0
    buffer_load_dwordx4 v1, s[20:23], s65 offen offset:0 nt lds
    buffer_load_dwordx4 v2, s[20:23], s65 offen offset:1024 nt lds
    buffer_load_dwordx4 v3, s[20:23], s65 offen offset:2048 nt lds
    buffer_load_dwordx4 v4, s[20:23], s65 offen offset:3072 nt lds
L_q0b:
    s_waitcnt vmcnt(0)
    ds_read_b128 v[40:43], v5 offset:0
    ds_read_b128 v[44:47], v6 offset:0
    ds_read_b128 v[48:51], v7 offset:0
    ds_read_b128 v[52:55], v8 offset:0
    s_waitcnt lgkmcnt(0)
    s_mov_b32 m0, s67
    s_nop 0
    buffer_load_dwordx4 v1, s[20:23], s66 offen offset:0 nt lds
    buffer_load_dwordx4 v2, s[20:23], s66 offen offset:1024 nt lds
    buffer_load_dwordx4 v3, s[20:23], s66 offen offset:2048 nt lds
    buffer_load_dwordx4 v4, s[20:23], s66 offen offset:3072 nt lds
    v_mfma_f32_16x16x32_bf16 v[72:75], v[104:107], v[40:43], 0
    v_dot2_f32_bf16 v16, v40, v40, 0
    v_mfma_f32_16x16x32_bf16 v[76:79], v[120:123], v[40:43], 0
    v_dot2_f32_bf16 v16, v41, v41, v16
    v_mfma_f32_16x16x32_bf16 v[80:83], v[136:139], v[40:43], 0
    v_dot2_f32_bf16 v16, v42, v42, v16
    v_mfma_f32_16x16x32_bf16 v[84:87], v[152:155], v[40:43], 0
    v_dot2_f32_bf16 v16, v43, v43, v16
    v_mfma_f32_16x16x32_bf16 v[72:75], v[108:111], v[44:47], v[72:75]
    v_dot2_f32_bf16 v16, v44, v44, v16
    v_mfma_f32_16x16x32_bf16 v[76:79], v[124:127], v[44:47], v[76:79]
    v_dot2_f32_bf16 v16, v45, v45, v16
    v_mfma_f32_16x16x32_bf16 v[80:83], v[140:143], v[44:47], v[80:83]
    v_dot2_f32_bf16 v16, v46, v46, v16
    v_mfma_f32_16x16x32_bf16 v[84:87], v[156:159], v[44:47], v[84:87]
    v_dot2_f32_bf16 v16, v47, v47, v16
    v_mfma_f32_16x16x32_bf16 v[72:75], v[112:115], v[48:51], v[72:75]
    v_dot2_f32_bf16 v16, v48, v48, v16
    v_mfma_f32_16x16x32_bf16 v[76:79], v[128:131], v[48:51], v[76:79]
    v_dot2_f32_bf16 v16, v49, v49, v16
    v_mfma_f32_16x16x32_bf16 v[80:83], v[144:147], v[48:51], v[80:83]
    v_dot2_f32_bf16 v16, v50, v50, v16
    v_mfma_f32_16x16x32_bf16 v[84:87], v[160:163], v[48:51], v[84:87]
    v_dot2_f32_bf16 v16, v51, v51, v16
    v_mfma_f32_16x16x32_bf16 v[72:75], v[116:119], v[52:55], v[72:75]
    v_dot2_f32_bf16 v16, v52, v52, v16
    v_mfma_f32_16x16x32_bf16 v[76:79], v[132:135], v[52:55], v[76:79]
    v_dot2_f32_bf16 v16, v53, v53, v16
    v_mfma_f32_16x16x32_bf16 v[80:83], v[148:151], v[52:55], v[80:83]
    v_dot2_f32_bf16 v16, v54, v54, v16
    v_mfma_f32_16x16x32_bf16 v[84:87], v[164:167], v[52:55], v[84:87]
    v_dot2_f32_bf16 v16, v55, v55, v16
    s_nop 2
    v_fma_f32 v16, v16, v13, v14
    v_cvt_pk_bf16_f32 v18, 0, v16
    v_sub_f32 v18, v16, v18
    v_cvt_pk_bf16_f32 v24, v16, v18
    s_nop 1
    v_mfma_f32_16x16x32_bf16 v[32:35], v[20:23], v[24:27], 0
    s_nop 7
    v_pk_fma_f32 v[72:73], v[72:73], s[56:57], v[32:33]
    v_pk_fma_f32 v[74:75], v[74:75], s[56:57], v[34:35]
    v_pk_fma_f32 v[76:77], v[76:77], s[56:57], v[32:33]
    v_pk_fma_f32 v[78:79], v[78:79], s[56:57], v[34:35]
    v_exp_f32 v72, v72
    v_exp_f32 v73, v73
    v_exp_f32 v74, v74
    v_exp_f32 v75, v75
    v_exp_f32 v76, v76
    v_exp_f32 v77, v77
    v_exp_f32 v78, v78
    v_exp_f32 v79, v79
    v_pk_add_f32 v[72:73], v[72:73], s[58:59]
    v_pk_add_f32 v[74:75], v[74:75], s[58:59]
    v_pk_add_f32 v[76:77], v[76:77], s[58:59]
    v_pk_add_f32 v[78:79], v[78:79], s[58:59]
    v_cvt_pk_bf16_f32 v72, v72, v73
    v_cvt_pk_bf16_f32 v73, v74, v75
    v_cvt_pk_bf16_f32 v74, v76, v77
    v_cvt_pk_bf16_f32 v75, v78, v79
    v_pk_fma_f32 v[80:81], v[80:81], s[56:57], v[32:33]
    v_pk_fma_f32 v[82:83], v[82:83], s[56:57], v[34:35]
    v_pk_fma_f32 v[84:85], v[84:85], s[56:57], v[32:33]
    v_pk_fma_f32 v[86:87], v[86:87], s[56:57], v[34:35]
    v_exp_f32 v80, v80
    v_exp_f32 v81, v81
    v_exp_f32 v82, v82
    v_exp_f32 v83, v83
    v_exp_f32 v84, v84
    v_exp_f32 v85, v85
    v_exp_f32 v86, v86
    v_exp_f32 v87, v87
    v_pk_add_f32 v[80:81], v[80:81], s[58:59]
    v_pk_add_f32 v[82:83], v[82:83], s[58:59]
    v_pk_add_f32 v[84:85], v[84:85], s[58:59]
    v_pk_add_f32 v[86:87], v[86:87], s[58:59]
    v_cvt_pk_bf16_f32 v80, v80, v81
    v_cvt_pk_bf16_f32 v81, v82, v83
    v_cvt_pk_bf16_f32 v82, v84, v85
    v_cvt_pk_bf16_f32 v83, v86, v87
    s_waitcnt vmcnt(0)
    ds_read_b128 v[56:59], v5 offset:0
    ds_read_b128 v[60:63], v6 offset:0
    ds_read_b128 v[64:67], v7 offset:0
    ds_read_b128 v[68:71], v8 offset:0
    s_waitcnt lgkmcnt(0)
    v_mfma_f32_16x16x32_bf16 v[88:91], v[104:107], v[56:59], 0
    v_dot2_f32_bf16 v17, v56, v56, 0
    v_mfma_f32_16x16x32_bf16 v[92:95], v[120:123], v[56:59], 0
    v_dot2_f32_bf16 v17, v57, v57, v17
    v_mfma_f32_16x16x32_bf16 v[96:99], v[136:139], v[56:59], 0
    v_dot2_f32_bf16 v17, v58, v58, v17
    v_mfma_f32_16x16x32_bf16 v[100:103], v[152:155], v[56:59], 0
    v_dot2_f32_bf16 v17, v59, v59, v17
    v_mfma_f32_16x16x32_bf16 v[88:91], v[108:111], v[60:63], v[88:91]
    v_dot2_f32_bf16 v17, v60, v60, v17
    v_mfma_f32_16x16x32_bf16 v[92:95], v[124:127], v[60:63], v[92:95]
    v_dot2_f32_bf16 v17, v61, v61, v17
    v_mfma_f32_16x16x32_bf16 v[96:99], v[140:143], v[60:63], v[96:99]
    v_dot2_f32_bf16 v17, v62, v62, v17
    v_mfma_f32_16x16x32_bf16 v[100:103], v[156:159], v[60:63], v[100:103]
    v_dot2_f32_bf16 v17, v63, v63, v17
    v_mfma_f32_16x16x32_bf16 v[88:91], v[112:115], v[64:67], v[88:91]
    v_dot2_f32_bf16 v17, v64, v64, v17
    v_mfma_f32_16x16x32_bf16 v[92:95], v[128:131], v[64:67], v[92:95]
    v_dot2_f32_bf16 v17, v65, v65, v17
    v_mfma_f32_16x16x32_bf16 v[96:99], v[144:147], v[64:67], v[96:99]
    v_dot2_f32_bf16 v17, v66, v66, v17
    v_mfma_f32_16x16x32_bf16 v[100:103], v[160:163], v[64:67], v[100:103]
    v_dot2_f32_bf16 v17, v67, v67, v17
    v_mfma_f32_16x16x32_bf16 v[88:91], v[116:119], v[68:71], v[88:91]
    v_dot2_f32_bf16 v17, v68, v68, v17
    v_mfma_f32_16x16x32_bf16 v[92:95], v[132:135], v[68:71], v[92:95]
    v_dot2_f32_bf16 v17, v69, v69, v17
    v_mfma_f32_16x16x32_bf16 v[96:99], v[148:151], v[68:71], v[96:99]
    v_dot2_f32_bf16 v17, v70, v70, v17
    v_mfma_f32_16x16x32_bf16 v[100:103], v[164:167], v[68:71], v[100:103]
    v_dot2_f32_bf16 v17, v71, v71, v17
    s_nop 2
    v_fma_f32 v17, v17, v13, v14
    v_cvt_pk_bf16_f32 v18, 0, v17
    v_sub_f32 v18, v17, v18
    v_cvt_pk_bf16_f32 v28, v17, v18
    s_nop 1
    v_mfma_f32_16x16x32_bf16 v[36:39], v[20:23], v[28:31], 0
    s_nop 7
    v_pk_fma_f32 v[88:89], v[88:89], s[56:57], v[36:37]
    v_pk_fma_f32 v[90:91], v[90:91], s[56:57], v[38:39]
    v_pk_fma_f32 v[92:93], v[92:93], s[56:57], v[36:37]
    v_pk_fma_f32 v[94:95], v[94:95], s[56:57], v[38:39]
    v_exp_f32 v88, v88
    v_exp_f32 v89, v89
    v_exp_f32 v90, v90
    v_exp_f32 v91, v91
    v_exp_f32 v92, v92
    v_exp_f32 v93, v93
    v_exp_f32 v94, v94
    v_exp_f32 v95, v95
    v_pk_add_f32 v[88:89], v[88:89], s[58:59]
    v_pk_add_f32 v[90:91], v[90:91], s[58:59]
    v_pk_add_f32 v[92:93], v[92:93], s[58:59]
    v_pk_add_f32 v[94:95], v[94:95], s[58:59]
    v_cvt_pk_bf16_f32 v88, v88, v89
    v_cvt_pk_bf16_f32 v89, v90, v91
    v_cvt_pk_bf16_f32 v90, v92, v93
    v_cvt_pk_bf16_f32 v91, v94, v95
    v_pk_fma_f32 v[96:97], v[96:97], s[56:57], v[36:37]
    v_pk_fma_f32 v[98:99], v[98:99], s[56:57], v[38:39]
    v_pk_fma_f32 v[100:101], v[100:101], s[56:57], v[36:37]
    v_pk_fma_f32 v[102:103], v[102:103], s[56:57], v[38:39]
    v_exp_f32 v96, v96
    v_exp_f32 v97, v97
    v_exp_f32 v98, v98
    v_exp_f32 v99, v99
    v_exp_f32 v100, v100
    v_exp_f32 v101, v101
    v_exp_f32 v102, v102
    v_exp_f32 v103, v103
    v_pk_add_f32 v[96:97], v[96:97], s[58:59]
    v_pk_add_f32 v[98:99], v[98:99], s[58:59]
    v_pk_add_f32 v[100:101], v[100:101], s[58:59]
    v_pk_add_f32 v[102:103], v[102:103], s[58:59]
    v_cvt_pk_bf16_f32 v96, v96, v97
    v_cvt_pk_bf16_f32 v97, v98, v99
    v_cvt_pk_bf16_f32 v98, v100, v101
    v_cvt_pk_bf16_f32 v99, v102, v103
    s_barrier
    ds_read_b128 v[24:27], v12 offset:0
    ds_read_b128 v[28:31], v12 offset:64
    ds_read_b128 v[104:107], v15 offset:0
    ds_read_b128 v[108:111], v15 offset:8320
    ds_read_b128 v[112:115], v15 offset:1040
    ds_read_b128 v[116:119], v15 offset:9360
    ds_read_b128 v[120:123], v15 offset:2080
    ds_read_b128 v[124:127], v15 offset:10400
    ds_read_b128 v[128:131], v15 offset:3120
    ds_read_b128 v[132:135], v15 offset:11440
    ds_read_b128 v[136:139], v15 offset:4160
    ds_read_b128 v[140:143], v15 offset:12480
    ds_read_b128 v[144:147], v15 offset:5200
    ds_read_b128 v[148:151], v15 offset:13520
    ds_read_b128 v[152:155], v15 offset:6240
    ds_read_b128 v[156:159], v15 offset:14560
    ds_read_b128 v[160:163], v15 offset:7280
    ds_read_b128 v[164:167], v15 offset:15600
    s_waitcnt lgkmcnt(15)
    v_mfma_f32_16x16x32_bf16 v[32:35], v[72:75], v[24:27], 0
    v_mfma_f32_16x16x32_bf16 v[32:35], v[80:83], v[28:31], v[32:35]
    s_waitcnt lgkmcnt(14)
    v_mfma_f32_16x16x32_bf16 v[40:43], v[72:75], v[104:107], 0
    v_mfma_f32_16x16x32_bf16 v[40:43], v[80:83], v[108:111], v[40:43]
    s_waitcnt lgkmcnt(12)
    v_mfma_f32_16x16x32_bf16 v[44:47], v[72:75], v[112:115], 0
    v_mfma_f32_16x16x32_bf16 v[44:47], v[80:83], v[116:119], v[44:47]
    s_waitcnt lgkmcnt(10)
    v_mfma_f32_16x16x32_bf16 v[48:51], v[72:75], v[120:123], 0
    v_mfma_f32_16x16x32_bf16 v[48:51], v[80:83], v[124:127], v[48:51]
    s_waitcnt lgkmcnt(8)
    v_mfma_f32_16x16x32_bf16 v[52:55], v[72:75], v[128:131], 0
    v_mfma_f32_16x16x32_bf16 v[52:55], v[80:83], v[132:135], v[52:55]
    s_waitcnt lgkmcnt(6)
    v_mfma_f32_16x16x32_bf16 v[56:59], v[72:75], v[136:139], 0
    v_mfma_f32_16x16x32_bf16 v[56:59], v[80:83], v[140:143], v[56:59]
    v_pk_add_f32 v[32:33], v[32:33], s[58:59]
    v_pk_add_f32 v[34:35], v[34:35], s[58:59]
    s_waitcnt lgkmcnt(4)
    v_mfma_f32_16x16x32_bf16 v[60:63], v[72:75], v[144:147], 0
    v_mfma_f32_16x16x32_bf16 v[60:63], v[80:83], v[148:151], v[60:63]
    v_rcp_f32 v32, v32
    v_rcp_f32 v33, v33
    s_waitcnt lgkmcnt(2)
    v_mfma_f32_16x16x32_bf16 v[64:67], v[72:75], v[152:155], 0
    v_mfma_f32_16x16x32_bf16 v[64:67], v[80:83], v[156:159], v[64:67]
    v_rcp_f32 v34, v34
    v_rcp_f32 v35, v35
    s_waitcnt lgkmcnt(0)
    v_mfma_f32_16x16x32_bf16 v[68:71], v[72:75], v[160:163], 0
    v_mfma_f32_16x16x32_bf16 v[68:71], v[80:83], v[164:167], v[68:71]
    v_pk_mul_f32 v[40:41], v[40:41], v[32:33]
    v_pk_mul_f32 v[42:43], v[42:43], v[34:35]
    v_pk_mul_f32 v[44:45], v[44:45], v[32:33]
    v_pk_mul_f32 v[46:47], v[46:47], v[34:35]
    v_pk_mul_f32 v[48:49], v[48:49], v[32:33]
    v_pk_mul_f32 v[50:51], v[50:51], v[34:35]
    v_pk_mul_f32 v[52:53], v[52:53], v[32:33]
    v_pk_mul_f32 v[54:55], v[54:55], v[34:35]
    v_pk_mul_f32 v[56:57], v[56:57], v[32:33]
    v_pk_mul_f32 v[58:59], v[58:59], v[34:35]
    v_pk_mul_f32 v[60:61], v[60:61], v[32:33]
    v_pk_mul_f32 v[62:63], v[62:63], v[34:35]
    v_pk_mul_f32 v[64:65], v[64:65], v[32:33]
    v_pk_mul_f32 v[66:67], v[66:67], v[34:35]
    v_pk_mul_f32 v[68:69], v[68:69], v[32:33]
    v_pk_mul_f32 v[70:71], v[70:71], v[34:35]
    v_cvt_pk_bf16_f32 v76, v40, v44
    v_cvt_pk_bf16_f32 v77, v48, v52
    v_cvt_pk_bf16_f32 v78, v56, v60
    v_cvt_pk_bf16_f32 v79, v64, v68
    buffer_store_dwordx4 v[76:79], v11, s[36:39], s65 offen offset:0 nt
    v_cvt_pk_bf16_f32 v84, v41, v45
    v_cvt_pk_bf16_f32 v85, v49, v53
    v_cvt_pk_bf16_f32 v86, v57, v61
    v_cvt_pk_bf16_f32 v87, v65, v69
    buffer_store_dwordx4 v[84:87], v11, s[36:39], s65 offen offset:256 nt
    v_cvt_pk_bf16_f32 v92, v42, v46
    v_cvt_pk_bf16_f32 v93, v50, v54
    v_cvt_pk_bf16_f32 v94, v58, v62
    v_cvt_pk_bf16_f32 v95, v66, v70
    buffer_store_dwordx4 v[92:95], v11, s[36:39], s65 offen offset:512 nt
    v_cvt_pk_bf16_f32 v100, v43, v47
    v_cvt_pk_bf16_f32 v101, v51, v55
    v_cvt_pk_bf16_f32 v102, v59, v63
    v_cvt_pk_bf16_f32 v103, v67, v71
    buffer_store_dwordx4 v[100:103], v11, s[36:39], s65 offen offset:768 nt
    v_mfma_f32_16x16x32_bf16 v[36:39], v[88:91], v[24:27], 0
    v_mfma_f32_16x16x32_bf16 v[36:39], v[96:99], v[28:31], v[36:39]
    v_mfma_f32_16x16x32_bf16 v[40:43], v[88:91], v[104:107], 0
    v_mfma_f32_16x16x32_bf16 v[40:43], v[96:99], v[108:111], v[40:43]
    v_mfma_f32_16x16x32_bf16 v[44:47], v[88:91], v[112:115], 0
    v_mfma_f32_16x16x32_bf16 v[44:47], v[96:99], v[116:119], v[44:47]
    v_mfma_f32_16x16x32_bf16 v[48:51], v[88:91], v[120:123], 0
    v_mfma_f32_16x16x32_bf16 v[48:51], v[96:99], v[124:127], v[48:51]
    v_mfma_f32_16x16x32_bf16 v[52:55], v[88:91], v[128:131], 0
    v_mfma_f32_16x16x32_bf16 v[52:55], v[96:99], v[132:135], v[52:55]
    v_mfma_f32_16x16x32_bf16 v[56:59], v[88:91], v[136:139], 0
    v_mfma_f32_16x16x32_bf16 v[56:59], v[96:99], v[140:143], v[56:59]
    v_pk_add_f32 v[36:37], v[36:37], s[58:59]
    v_pk_add_f32 v[38:39], v[38:39], s[58:59]
    v_mfma_f32_16x16x32_bf16 v[60:63], v[88:91], v[144:147], 0
    v_mfma_f32_16x16x32_bf16 v[60:63], v[96:99], v[148:151], v[60:63]
    v_rcp_f32 v36, v36
    v_rcp_f32 v37, v37
    v_mfma_f32_16x16x32_bf16 v[64:67], v[88:91], v[152:155], 0
    v_mfma_f32_16x16x32_bf16 v[64:67], v[96:99], v[156:159], v[64:67]
    v_rcp_f32 v38, v38
    v_rcp_f32 v39, v39
    v_mfma_f32_16x16x32_bf16 v[68:71], v[88:91], v[160:163], 0
    v_mfma_f32_16x16x32_bf16 v[68:71], v[96:99], v[164:167], v[68:71]
    v_pk_mul_f32 v[40:41], v[40:41], v[36:37]
    v_pk_mul_f32 v[42:43], v[42:43], v[38:39]
    v_pk_mul_f32 v[44:45], v[44:45], v[36:37]
    v_pk_mul_f32 v[46:47], v[46:47], v[38:39]
    v_pk_mul_f32 v[48:49], v[48:49], v[36:37]
    v_pk_mul_f32 v[50:51], v[50:51], v[38:39]
    v_pk_mul_f32 v[52:53], v[52:53], v[36:37]
    v_pk_mul_f32 v[54:55], v[54:55], v[38:39]
    v_pk_mul_f32 v[56:57], v[56:57], v[36:37]
    v_pk_mul_f32 v[58:59], v[58:59], v[38:39]
    v_pk_mul_f32 v[60:61], v[60:61], v[36:37]
    v_pk_mul_f32 v[62:63], v[62:63], v[38:39]
    v_pk_mul_f32 v[64:65], v[64:65], v[36:37]
    v_pk_mul_f32 v[66:67], v[66:67], v[38:39]
    v_pk_mul_f32 v[68:69], v[68:69], v[36:37]
    v_pk_mul_f32 v[70:71], v[70:71], v[38:39]
    v_cvt_pk_bf16_f32 v76, v40, v44
    v_cvt_pk_bf16_f32 v77, v48, v52
    v_cvt_pk_bf16_f32 v78, v56, v60
    v_cvt_pk_bf16_f32 v79, v64, v68
    buffer_store_dwordx4 v[76:79], v11, s[36:39], s66 offen offset:0 nt
    v_cvt_pk_bf16_f32 v84, v41, v45
    v_cvt_pk_bf16_f32 v85, v49, v53
    v_cvt_pk_bf16_f32 v86, v57, v61
    v_cvt_pk_bf16_f32 v87, v65, v69
    buffer_store_dwordx4 v[84:87], v11, s[36:39], s66 offen offset:256 nt
    v_cvt_pk_bf16_f32 v92, v42, v46
    v_cvt_pk_bf16_f32 v93, v50, v54
    v_cvt_pk_bf16_f32 v94, v58, v62
    v_cvt_pk_bf16_f32 v95, v66, v70
    buffer_store_dwordx4 v[92:95], v11, s[36:39], s66 offen offset:512 nt
    v_cvt_pk_bf16_f32 v100, v43, v47
    v_cvt_pk_bf16_f32 v101, v51, v55
    v_cvt_pk_bf16_f32 v102, v59, v63
    v_cvt_pk_bf16_f32 v103, v67, v71
    buffer_store_dwordx4 v[100:103], v11, s[36:39], s66 offen offset:768 nt
    s_endpgm
L_v2:
    s_barrier
    s_add_u32 s52, s66, 0
    s_mov_b32 m0, s52
    s_add_u32 s53, s12, 0
    buffer_load_dwordx4 v1, s[28:31], s53 offen offset:0 nt lds
    buffer_load_dwordx4 v1, s[28:31], s53 offen offset:1024 nt lds
    buffer_store_dwordx4 v[88:91], v2, s[20:23], s90 offen offset:0
    buffer_store_dwordx4 v[88:91], v2, s[20:23], s90 offen offset:1024
    buffer_store_dwordx4 v[88:91], v2, s[20:23], s90 offen offset:2048
    buffer_store_dwordx4 v[88:91], v2, s[20:23], s90 offen offset:3072
    buffer_store_dwordx2 v[88:89], v106, s[44:47], s10 offen
    s_mov_b64 exec, 0xffff
    buffer_store_dword v88, v167, s[20:23], s90 offen
    s_mov_b64 exec, -1
    s_add_u32 s52, s66, 8192
    s_mov_b32 m0, s52
    s_add_u32 s53, s12, 8192
    buffer_load_dwordx4 v1, s[28:31], s53 offen offset:0 nt lds
    buffer_load_dwordx4 v1, s[28:31], s53 offen offset:1024 nt lds
    s_add_u32 s52, s66, 16384
    s_mov_b32 m0, s52
    s_add_u32 s53, s12, 16384
    buffer_load_dwordx4 v1, s[28:31], s53 offen offset:0 nt lds
    buffer_load_dwordx4 v1, s[28:31], s53 offen offset:1024 nt lds
    s_add_u32 s52, s66, 24576
    s_mov_b32 m0, s52
    s_add_u32 s53, s12, 24576
    buffer_load_dwordx4 v1, s[28:31], s53 offen offset:0 nt lds
    buffer_load_dwordx4 v1, s[28:31], s53 offen offset:1024 nt lds
    s_waitcnt vmcnt(6)
    v_readfirstlane_b32 s68, v8
    s_nop 3
    s_add_u32 s68, s68, 1
    s_xor_b32 s69, s68, 0x5bd1e990
    s_andn2_b32 s69, s69, 15
    s_or_b32 s69, s69, s54
    v_mov_b32 v10, s68
    v_mov_b32 v11, s69
    s_mov_b64 exec, 1
    buffer_store_dwordx2 v[10:11], off, s[44:47], s11 sc1
    s_mov_b64 exec, -1
    s_add_u32 s52, s66, 32768
    s_mov_b32 m0, s52
    s_add_u32 s53, s12, 32768
    buffer_load_dwordx4 v1, s[28:31], s53 offen offset:0 nt lds
    buffer_load_dwordx4 v1, s[28:31], s53 offen offset:1024 nt lds
    s_add_u32 s52, s66, 40960
    s_mov_b32 m0, s52
    s_add_u32 s53, s12, 40960
    buffer_load_dwordx4 v1, s[28:31], s53 offen offset:0 nt lds
    buffer_load_dwordx4 v1, s[28:31], s53 offen offset:1024 nt lds
    s_add_u32 s52, s66, 49152
    s_mov_b32 m0, s52
    s_add_u32 s53, s12, 49152
    buffer_load_dwordx4 v1, s[28:31], s53 offen offset:0 nt lds
    buffer_load_dwordx4 v1, s[28:31], s53 offen offset:1024 nt lds
    v_lshlrev_b32 v13, 7, v0
    s_mov_b32 exec_lo, -1
    s_mov_b32 exec_hi, 1
    buffer_load_dword v14, v13, s[20:23], s90 offen nt
    s_mov_b64 exec, 15
    buffer_load_dword v14, v13, s[44:47], s10 offen nt
    s_mov_b64 exec, -1
    s_add_u32 s52, s66, 57344
    s_mov_b32 m0, s52
    s_add_u32 s53, s12, 57344
    buffer_load_dwordx4 v1, s[28:31], s53 offen offset:0 nt lds
    buffer_load_dwordx4 v1, s[28:31], s53 offen offset:1024 nt lds
    buffer_load_dwordx2 v[10:11], v15, s[44:47], s67 offen sc1
    s_waitcnt vmcnt(16)
    s_barrier
    ds_read_b128 v[48:51], v3 offset:0
    ds_read_b128 v[52:55], v3 offset:512
    ds_read_b128 v[56:59], v3 offset:2048
    ds_read_b128 v[60:63], v3 offset:2560
    ds_read_b64_tr_b16 v[80:81], v4 offset:0
    ds_read_b64_tr_b16 v[82:83], v4 offset:4096
    ds_read_b64_tr_b16 v[84:85], v4 offset:2048
    ds_read_b64_tr_b16 v[86:87], v4 offset:6144
    ds_read_b128 v[64:67], v3 offset:8192
    ds_read_b128 v[68:71], v3 offset:8704
    ds_read_b128 v[72:75], v3 offset:10240
    ds_read_b128 v[76:79], v3 offset:10752
    ds_read_b64_tr_b16 v[116:117], v4 offset:8192
    ds_read_b64_tr_b16 v[118:119], v4 offset:12288
    ds_read_b64_tr_b16 v[120:121], v4 offset:10240
    ds_read_b64_tr_b16 v[122:123], v4 offset:14336
    s_waitcnt lgkmcnt(10)
    v_mfma_f32_32x32x16_bf16 v[16:31], v[48:51], v[80:83], 0
    v_mfma_f32_32x32x16_bf16 v[32:47], v[52:55], v[80:83], 0
    s_waitcnt lgkmcnt(8)
    v_mfma_f32_32x32x16_bf16 v[16:31], v[56:59], v[84:87], v[16:31]
    v_mfma_f32_32x32x16_bf16 v[32:47], v[60:63], v[84:87], v[32:47]
    v_mov_b32 v9, 4
    s_waitcnt vmcnt(12)
    ds_write_b32 v109, v9
    ds_read_b128 v[124:127], v3 offset:16384
    ds_read_b128 v[128:131], v3 offset:16896
    ds_read_b128 v[132:135], v3 offset:18432
    ds_read_b128 v[136:139], v3 offset:18944
    ds_read_b128 v[140:143], v3 offset:24576
    ds_read_b128 v[144:147], v3 offset:25088
    ds_read_b128 v[148:151], v3 offset:26624
    ds_read_b128 v[152:155], v3 offset:27136
    s_waitcnt lgkmcnt(11)
    v_mfma_f32_32x32x16_bf16 v[16:31], v[64:67], v[116:119], v[16:31]
    v_mfma_f32_32x32x16_bf16 v[32:47], v[68:71], v[116:119], v[32:47]
    s_waitcnt lgkmcnt(9)
    ds_read_b128 v[112:115], v108
    v_mfma_f32_32x32x16_bf16 v[16:31], v[72:75], v[120:123], v[16:31]
    v_mfma_f32_32x32x16_bf16 v[32:47], v[76:79], v[120:123], v[32:47]
    s_branch L_vc3
L_vr3:
    ds_read_b128 v[112:115], v108
L_vc3:
    s_waitcnt lgkmcnt(0)
    v_min3_u32 v9, v112, v113, v114
    v_min_u32 v9, v9, v115
    v_cmp_ge_u32 vcc, 3, v9
    s_nop 4
    s_cbranch_vccnz L_vr3
    ds_read_b64_tr_b16 v[88:89], v4 offset:16384
    ds_read_b64_tr_b16 v[90:91], v4 offset:20480
    ds_read_b64_tr_b16 v[92:93], v4 offset:18432
    ds_read_b64_tr_b16 v[94:95], v4 offset:22528
    ds_read_b64_tr_b16 v[96:97], v4 offset:24576
    ds_read_b64_tr_b16 v[98:99], v4 offset:28672
    ds_read_b64_tr_b16 v[100:101], v4 offset:26624
    ds_read_b64_tr_b16 v[102:103], v4 offset:30720
    ds_read_b32 v156, v12 offset:0
    ds_read_b32 v157, v12 offset:256
    ds_read_b32 v158, v12 offset:512
    ds_read_b32 v159, v12 offset:768
    ds_read_b32 v160, v12 offset:1024
    ds_read_b32 v161, v12 offset:1280
    ds_read_b32 v162, v12 offset:1536
    ds_read_b32 v163, v12 offset:1792
    s_waitcnt lgkmcnt(14)
    v_mfma_f32_32x32x16_bf16 v[16:31], v[124:127], v[88:91], v[16:31]
    v_mfma_f32_32x32x16_bf16 v[32:47], v[128:131], v[88:91], v[32:47]
    s_waitcnt lgkmcnt(12)
    v_mfma_f32_32x32x16_bf16 v[16:31], v[132:135], v[92:95], v[16:31]
    v_mfma_f32_32x32x16_bf16 v[32:47], v[136:139], v[92:95], v[32:47]
    v_mov_b32 v9, 6
    s_waitcnt vmcnt(7)
    ds_write_b32 v109, v9
    ds_read_b128 v[48:51], v3 offset:32768
    ds_read_b128 v[52:55], v3 offset:33280
    ds_read_b128 v[56:59], v3 offset:34816
    ds_read_b128 v[60:63], v3 offset:35328
    ds_read_b128 v[64:67], v3 offset:40960
    ds_read_b128 v[68:71], v3 offset:41472
    ds_read_b128 v[72:75], v3 offset:43008
    ds_read_b128 v[76:79], v3 offset:43520
    s_waitcnt lgkmcnt(15)
    v_mfma_f32_32x32x16_bf16 v[16:31], v[140:143], v[96:99], v[16:31]
    v_mfma_f32_32x32x16_bf16 v[32:47], v[144:147], v[96:99], v[32:47]
    s_waitcnt lgkmcnt(15)
    ds_read_b128 v[112:115], v108
    v_mfma_f32_32x32x16_bf16 v[16:31], v[148:151], v[100:103], v[16:31]
    v_mfma_f32_32x32x16_bf16 v[32:47], v[152:155], v[100:103], v[32:47]
    s_branch L_vc5
L_vr5:
    ds_read_b128 v[112:115], v108
L_vc5:
    s_waitcnt lgkmcnt(0)
    v_min3_u32 v9, v112, v113, v114
    v_min_u32 v9, v9, v115
    v_cmp_ge_u32 vcc, 5, v9
    s_nop 4
    s_cbranch_vccnz L_vr5
    ds_read_b64_tr_b16 v[80:81], v4 offset:32768
    ds_read_b64_tr_b16 v[82:83], v4 offset:36864
    ds_read_b64_tr_b16 v[84:85], v4 offset:34816
    ds_read_b64_tr_b16 v[86:87], v4 offset:38912
    ds_read_b64_tr_b16 v[116:117], v4 offset:40960
    ds_read_b64_tr_b16 v[118:119], v4 offset:45056
    ds_read_b64_tr_b16 v[120:121], v4 offset:43008
    ds_read_b64_tr_b16 v[122:123], v4 offset:47104
    v_add_f32 v8, v156, v157
    v_add_f32 v8, v8, v158
    v_add_f32 v8, v8, v159
    v_add_f32 v8, v8, v160
    v_add_f32 v8, v8, v161
    v_add_f32 v8, v8, v162
    v_add_f32 v8, v8, v163
    v_min_u32 v8, -2, v8
    ds_read_b128 v[124:127], v3 offset:49152
    ds_read_b128 v[128:131], v3 offset:49664
    ds_read_b128 v[132:135], v3 offset:51200
    ds_read_b128 v[136:139], v3 offset:51712
    ds_read_b128 v[140:143], v3 offset:57344
    ds_read_b128 v[144:147], v3 offset:57856
    ds_read_b128 v[148:151], v3 offset:59392
    ds_read_b128 v[152:155], v3 offset:59904
    s_waitcnt lgkmcnt(14)
    v_mfma_f32_32x32x16_bf16 v[16:31], v[48:51], v[80:83], v[16:31]
    v_mfma_f32_32x32x16_bf16 v[32:47], v[52:55], v[80:83], v[32:47]
    s_waitcnt lgkmcnt(12)
    v_mfma_f32_32x32x16_bf16 v[16:31], v[56:59], v[84:87], v[16:31]
    v_mfma_f32_32x32x16_bf16 v[32:47], v[60:63], v[84:87], v[32:47]
    s_waitcnt lgkmcnt(10)
    v_mfma_f32_32x32x16_bf16 v[16:31], v[64:67], v[116:119], v[16:31]
    v_mfma_f32_32x32x16_bf16 v[32:47], v[68:71], v[116:119], v[32:47]
    s_waitcnt lgkmcnt(8)
    v_mfma_f32_32x32x16_bf16 v[16:31], v[72:75], v[120:123], v[16:31]
    v_mfma_f32_32x32x16_bf16 v[32:47], v[76:79], v[120:123], v[32:47]
    v_mov_b32 v9, 7
    s_waitcnt vmcnt(5)
    ds_write_b32 v109, v9
    ds_read_b128 v[112:115], v108
    s_branch L_vc6
L_vr6:
    ds_read_b128 v[112:115], v108
L_vc6:
    s_waitcnt lgkmcnt(0)
    v_min3_u32 v9, v112, v113, v114
    v_min_u32 v9, v9, v115
    v_cmp_ge_u32 vcc, 6, v9
    s_nop 4
    s_cbranch_vccnz L_vr6
    ds_read_b64_tr_b16 v[88:89], v4 offset:49152
    ds_read_b64_tr_b16 v[90:91], v4 offset:53248
    ds_read_b64_tr_b16 v[92:93], v4 offset:51200
    ds_read_b64_tr_b16 v[94:95], v4 offset:55296
    s_waitcnt lgkmcnt(2)
    v_mfma_f32_32x32x16_bf16 v[16:31], v[124:127], v[88:91], v[16:31]
    v_mfma_f32_32x32x16_bf16 v[32:47], v[128:131], v[88:91], v[32:47]
    s_waitcnt lgkmcnt(0)
    v_mfma_f32_32x32x16_bf16 v[16:31], v[132:135], v[92:95], v[16:31]
    v_mfma_f32_32x32x16_bf16 v[32:47], v[136:139], v[92:95], v[32:47]
    v_mov_b32 v9, 8
    s_waitcnt vmcnt(1)
    ds_write_b32 v109, v9
    ds_read_b128 v[112:115], v108
    s_branch L_vc7
L_vr7:
    ds_read_b128 v[112:115], v108
L_vc7:
    s_waitcnt lgkmcnt(0)
    v_min3_u32 v9, v112, v113, v114
    v_min_u32 v9, v9, v115
    v_cmp_ge_u32 vcc, 7, v9
    s_nop 4
    s_cbranch_vccnz L_vr7
    ds_read_b64_tr_b16 v[96:97], v4 offset:57344
    ds_read_b64_tr_b16 v[98:99], v4 offset:61440
    ds_read_b64_tr_b16 v[100:101], v4 offset:59392
    ds_read_b64_tr_b16 v[102:103], v4 offset:63488
    s_waitcnt lgkmcnt(2)
    v_mfma_f32_32x32x16_bf16 v[16:31], v[140:143], v[96:99], v[16:31]
    v_mfma_f32_32x32x16_bf16 v[32:47], v[144:147], v[96:99], v[32:47]
    s_waitcnt lgkmcnt(0)
    v_mfma_f32_32x32x16_bf16 v[16:31], v[148:151], v[100:103], v[16:31]
    v_mfma_f32_32x32x16_bf16 v[32:47], v[152:155], v[100:103], v[32:47]
    s_mov_b32 s55, 0
    s_waitcnt vmcnt(0)
L_fchk:
    v_xor_b32 v9, s69, v11
    v_cmp_ne_u32 vcc, s68, v10
    v_cmp_lt_u32 s[62:63], 15, v9
    v_cmp_ne_u32 s[92:93], 0, v9
    s_nop 2
    s_or_b64 s[62:63], s[62:63], vcc
    s_cbranch_scc0 L_fok
    s_add_u32 s55, s55, 1
    s_cmp_gt_u32 s55, 0x200000
    s_cbranch_scc1 L_fok
    buffer_load_dwordx2 v[10:11], v15, s[44:47], s67 offen sc1
    s_waitcnt vmcnt(0)
    s_branch L_fchk
L_fok:
    s_mov_b32 s55, 0
    s_cmp_lg_u64 s[92:93], 0
    s_cselect_b32 s91, 0, 1
    s_cbranch_scc1 L_g1
    s_mov_b64 exec, 0xffff
    buffer_store_dword v8, v167, s[20:23], s90 offen
    s_mov_b64 exec, -1
    v_cvt_pk_bf16_f32 v88, v16, v17
    v_cvt_pk_bf16_f32 v89, v18, v19
    v_cvt_pk_bf16_f32 v90, v20, v21
    v_cvt_pk_bf16_f32 v91, v22, v23
    v_min_u32 v88, -2, v88
    v_min_u32 v89, -2, v89
    v_min_u32 v90, -2, v90
    v_min_u32 v91, -2, v91
    buffer_store_dwordx4 v[88:91], v2, s[20:23], s90 offen offset:0
    v_cvt_pk_bf16_f32 v92, v24, v25
    v_cvt_pk_bf16_f32 v93, v26, v27
    v_cvt_pk_bf16_f32 v94, v28, v29
    v_cvt_pk_bf16_f32 v95, v30, v31
    v_min_u32 v92, -2, v92
    v_min_u32 v93, -2, v93
    v_min_u32 v94, -2, v94
    v_min_u32 v95, -2, v95
    buffer_store_dwordx4 v[92:95], v2, s[20:23], s90 offen offset:1024
    v_cvt_pk_bf16_f32 v96, v32, v33
    v_cvt_pk_bf16_f32 v97, v34, v35
    v_cvt_pk_bf16_f32 v98, v36, v37
    v_cvt_pk_bf16_f32 v99, v38, v39
    v_min_u32 v96, -2, v96
    v_min_u32 v97, -2, v97
    v_min_u32 v98, -2, v98
    v_min_u32 v99, -2, v99
    buffer_store_dwordx4 v[96:99], v2, s[20:23], s90 offen offset:2048
    v_cvt_pk_bf16_f32 v100, v40, v41
    v_cvt_pk_bf16_f32 v101, v42, v43
    v_cvt_pk_bf16_f32 v102, v44, v45
    v_cvt_pk_bf16_f32 v103, v46, v47
    v_min_u32 v100, -2, v100
    v_min_u32 v101, -2, v101
    v_min_u32 v102, -2, v102
    v_min_u32 v103, -2, v103
    buffer_store_dwordx4 v[100:103], v2, s[20:23], s90 offen offset:3072
L_r1:
    buffer_load_dwordx4 v[48:51], v104, s[20:23], s4 offen sc1
    buffer_load_dwordx4 v[52:55], v104, s[20:23], s5 offen sc1
    buffer_load_dwordx4 v[56:59], v104, s[20:23], s6 offen sc1
    buffer_load_dwordx4 v[60:63], v104, s[20:23], s7 offen sc1
    buffer_load_dwordx2 v[64:65], v105, s[20:23], s8 offen sc1
    s_barrier
L_p1:
    s_waitcnt vmcnt(0)
    v_max3_u32 v9, v48, v49, v50
    v_max_u32 v9, v9, v51
    v_cmp_eq_u32 s[92:93], -1, v9
    v_max3_u32 v10, v52, v53, v54
    v_max_u32 v10, v10, v55
    v_cmp_eq_u32 s[94:95], -1, v10
    v_max3_u32 v9, v56, v57, v58
    v_max_u32 v9, v9, v59
    v_cmp_eq_u32 s[96:97], -1, v9
    v_max3_u32 v10, v60, v61, v62
    v_max_u32 v10, v10, v63
    v_cmp_eq_u32 s[98:99], -1, v10
    v_max_u32 v9, v64, v65
    v_cmp_eq_u32 s[100:101], -1, v9
    s_nop 2
    s_or_b64 s[62:63], s[92:93], s[94:95]
    s_or_b64 s[62:63], s[62:63], s[96:97]
    s_or_b64 s[62:63], s[62:63], s[98:99]
    s_or_b64 s[62:63], s[62:63], s[100:101]
    s_cbranch_scc0 L_p1_done
    s_add_u32 s55, s55, 1
    s_cmp_gt_u32 s55, 0x200000
    s_cbranch_scc1 L_p1_done
    s_mov_b64 exec, s[92:93]
    s_cbranch_execz L_p1_s0
    buffer_load_dwordx4 v[48:51], v104, s[20:23], s4 offen sc1
L_p1_s0:
    s_mov_b64 exec, s[94:95]
    s_cbranch_execz L_p1_s1
    buffer_load_dwordx4 v[52:55], v104, s[20:23], s5 offen sc1
L_p1_s1:
    s_mov_b64 exec, s[96:97]
    s_cbranch_execz L_p1_s2
    buffer_load_dwordx4 v[56:59], v104, s[20:23], s6 offen sc1
L_p1_s2:
    s_mov_b64 exec, s[98:99]
    s_cbranch_execz L_p1_s3
    buffer_load_dwordx4 v[60:63], v104, s[20:23], s7 offen sc1
L_p1_s3:
    s_mov_b64 exec, s[100:101]
    s_cbranch_execz L_p1_s4
    buffer_load_dwordx2 v[64:65], v105, s[20:23], s8 offen sc1
L_p1_s4:
    s_mov_b64 exec, -1
    s_branch L_p1
L_p1_done:
    v_dot2_f32_bf16 v66, v48, s60, 0
    v_dot2_f32_bf16 v67, v48, s61, 0
    v_dot2_f32_bf16 v68, v49, s60, 0
    v_dot2_f32_bf16 v69, v49, s61, 0
    v_dot2_f32_bf16 v70, v50, s60, 0
    v_dot2_f32_bf16 v71, v50, s61, 0
    v_dot2_f32_bf16 v72, v51, s60, 0
    v_dot2_f32_bf16 v73, v51, s61, 0
    v_dot2_f32_bf16 v66, v52, s60, v66
    v_dot2_f32_bf16 v67, v52, s61, v67
    v_dot2_f32_bf16 v68, v53, s60, v68
    v_dot2_f32_bf16 v69, v53, s61, v69
    v_dot2_f32_bf16 v70, v54, s60, v70
    v_dot2_f32_bf16 v71, v54, s61, v71
    v_dot2_f32_bf16 v72, v55, s60, v72
    v_dot2_f32_bf16 v73, v55, s61, v73
    v_dot2_f32_bf16 v66, v56, s60, v66
    v_dot2_f32_bf16 v67, v56, s61, v67
    v_dot2_f32_bf16 v68, v57, s60, v68
    v_dot2_f32_bf16 v69, v57, s61, v69
    v_dot2_f32_bf16 v70, v58, s60, v70
    v_dot2_f32_bf16 v71, v58, s61, v71
    v_dot2_f32_bf16 v72, v59, s60, v72
    v_dot2_f32_bf16 v73, v59, s61, v73
    v_dot2_f32_bf16 v66, v60, s60, v66
    v_dot2_f32_bf16 v67, v60, s61, v67
    v_dot2_f32_bf16 v68, v61, s60, v68
    v_dot2_f32_bf16 v69, v61, s61, v69
    v_dot2_f32_bf16 v70, v62, s60, v70
    v_dot2_f32_bf16 v71, v62, s61, v71
    v_dot2_f32_bf16 v72, v63, s60, v72
    v_dot2_f32_bf16 v73, v63, s61, v73
    v_permlane32_swap_b32 v66, v70
    v_permlane32_swap_b32 v67, v71
    v_permlane32_swap_b32 v68, v72
    v_permlane32_swap_b32 v69, v73
    v_add_f32 v66, v66, v70
    v_add_f32 v67, v67, v71
    v_add_f32 v68, v68, v72
    v_add_f32 v69, v69, v73
    v_cvt_pk_bf16_f32 v70, v66, v67
    v_cvt_pk_bf16_f32 v71, v68, v69
    v_min_u32 v70, -2, v70
    v_min_u32 v71, -2, v71
    s_cmp_eq_u32 s91, 0
    s_cbranch_scc1 L_g2
    buffer_store_dwordx2 v[70:71], v106, s[44:47], s10 offen
L_r2:
    v_add_f32_dpp v64, v64, v64 row_ror:8 row_mask:0xf bank_mask:0xf
    v_add_f32_dpp v65, v65, v65 row_ror:8 row_mask:0xf bank_mask:0xf
    s_nop 1
    v_permlane16_swap_b32 v64, v65
    v_add_f32 v64, v64, v65
    v_mov_b32 v65, v64
    s_nop 1
    v_permlane32_swap_b32 v64, v65
    v_add_f32 v64, v64, v65
    v_cvt_pk_bf16_f32 v64, v64, 0
    ds_write_b16 v7, v64
    buffer_load_dwordx4 v[48:51], v2, s[44:47], s9 offen offset:0 sc1
    buffer_load_dwordx4 v[52:55], v2, s[44:47], s9 offen offset:1024 sc1
    buffer_load_dwordx4 v[56:59], v2, s[44:47], s9 offen offset:2048 sc1
    buffer_load_dwordx4 v[60:63], v2, s[44:47], s9 offen offset:3072 sc1
L_p2:
    s_waitcnt vmcnt(0)
    v_max3_u32 v9, v48, v49, v50
    v_max_u32 v9, v9, v51
    v_cmp_eq_u32 s[92:93], -1, v9
    v_max3_u32 v10, v52, v53, v54
    v_max_u32 v10, v10, v55
    v_cmp_eq_u32 s[94:95], -1, v10
    v_max3_u32 v9, v56, v57, v58
    v_max_u32 v9, v9, v59
    v_cmp_eq_u32 s[96:97], -1, v9
    v_max3_u32 v10, v60, v61, v62
    v_max_u32 v10, v10, v63
    v_cmp_eq_u32 s[98:99], -1, v10
    s_nop 2
    s_or_b64 s[62:63], s[92:93], s[94:95]
    s_or_b64 s[62:63], s[62:63], s[96:97]
    s_or_b64 s[62:63], s[62:63], s[98:99]
    s_cbranch_scc0 L_p2_done
    s_add_u32 s55, s55, 1
    s_cmp_gt_u32 s55, 0x200000
    s_cbranch_scc1 L_p2_done
    s_mov_b64 exec, s[92:93]
    s_cbranch_execz L_p2_s0
    buffer_load_dwordx4 v[48:51], v2, s[44:47], s9 offen offset:0 sc1
L_p2_s0:
    s_mov_b64 exec, s[94:95]
    s_cbranch_execz L_p2_s1
    buffer_load_dwordx4 v[52:55], v2, s[44:47], s9 offen offset:1024 sc1
L_p2_s1:
    s_mov_b64 exec, s[96:97]
    s_cbranch_execz L_p2_s2
    buffer_load_dwordx4 v[56:59], v2, s[44:47], s9 offen offset:2048 sc1
L_p2_s2:
    s_mov_b64 exec, s[98:99]
    s_cbranch_execz L_p2_s3
    buffer_load_dwordx4 v[60:63], v2, s[44:47], s9 offen offset:3072 sc1
L_p2_s3:
    s_mov_b64 exec, -1
    s_branch L_p2
L_p2_done:
    ds_write_b128 v5, v[48:51] offset:0
    ds_write_b128 v5, v[52:55] offset:512
    ds_write_b128 v5, v[56:59] offset:8320
    ds_write_b128 v5, v[60:63] offset:8832
    s_waitcnt lgkmcnt(0)
    s_barrier
    s_cmp_lg_u32 s51, 0
    s_cbranch_scc1 L_noep
    s_mov_b64 exec, 1
    v_mov_b32 v12, s68
    buffer_store_dword v12, off, s[44:47], s67 offset:128 sc1
    s_mov_b64 exec, -1
L_noep:
L_end:
    s_endpgm
L_g1:
    s_nop 7
    s_nop 3
    s_add_u32 s9, s9, 524288
    s_add_u32 s10, s10, 524288
    s_add_u32 s20, s44, 0
    s_addc_u32 s21, s45, 0
    s_mov_b64 exec, 0xffff
    buffer_store_dword v8, v167, s[20:23], s90 offen sc1
    s_mov_b64 exec, -1
    v_cvt_pk_bf16_f32 v88, v16, v17
    v_cvt_pk_bf16_f32 v89, v18, v19
    v_cvt_pk_bf16_f32 v90, v20, v21
    v_cvt_pk_bf16_f32 v91, v22, v23
    v_min_u32 v88, -2, v88
    v_min_u32 v89, -2, v89
    v_min_u32 v90, -2, v90
    v_min_u32 v91, -2, v91
    buffer_store_dwordx4 v[88:91], v2, s[20:23], s90 offen offset:0 sc1
    v_cvt_pk_bf16_f32 v92, v24, v25
    v_cvt_pk_bf16_f32 v93, v26, v27
    v_cvt_pk_bf16_f32 v94, v28, v29
    v_cvt_pk_bf16_f32 v95, v30, v31
    v_min_u32 v92, -2, v92
    v_min_u32 v93, -2, v93
    v_min_u32 v94, -2, v94
    v_min_u32 v95, -2, v95
    buffer_store_dwordx4 v[92:95], v2, s[20:23], s90 offen offset:1024 sc1
    v_cvt_pk_bf16_f32 v96, v32, v33
    v_cvt_pk_bf16_f32 v97, v34, v35
    v_cvt_pk_bf16_f32 v98, v36, v37
    v_cvt_pk_bf16_f32 v99, v38, v39
    v_min_u32 v96, -2, v96
    v_min_u32 v97, -2, v97
    v_min_u32 v98, -2, v98
    v_min_u32 v99, -2, v99
    buffer_store_dwordx4 v[96:99], v2, s[20:23], s90 offen offset:2048 sc1
    v_cvt_pk_bf16_f32 v100, v40, v41
    v_cvt_pk_bf16_f32 v101, v42, v43
    v_cvt_pk_bf16_f32 v102, v44, v45
    v_cvt_pk_bf16_f32 v103, v46, v47
    v_min_u32 v100, -2, v100
    v_min_u32 v101, -2, v101
    v_min_u32 v102, -2, v102
    v_min_u32 v103, -2, v103
    buffer_store_dwordx4 v[100:103], v2, s[20:23], s90 offen offset:3072 sc1
    s_xor_b32 s52, s68, 0x1b873593
    v_mov_b32 v10, s68
    v_mov_b32 v11, s52
    s_waitcnt vmcnt(0)
    s_mov_b64 exec, 1
    buffer_store_dwordx2 v[10:11], off, s[44:47], s11 offset:64 sc1
    s_mov_b64 exec, -1
    s_mov_b32 s53, 0
L_gs1:
    buffer_load_dwordx2 v[10:11], v15, s[44:47], s67 offen offset:64 sc1
    s_add_u32 s53, s53, 1
    s_waitcnt vmcnt(0)
    v_cmp_ne_u32 vcc, s68, v10
    v_cmp_ne_u32 s[62:63], s52, v11
    s_nop 3
    s_or_b64 s[62:63], s[62:63], vcc
    s_cbranch_scc0 L_r1
    s_cmp_gt_u32 s53, 0x200000
    s_cbranch_scc1 L_r1
    s_sleep 1
    s_branch L_gs1
L_g2:
    buffer_store_dwordx2 v[70:71], v106, s[44:47], s10 offen sc1
    s_xor_b32 s52, s68, 0x2545f491
    v_mov_b32 v10, s68
    v_mov_b32 v11, s52
    s_waitcnt vmcnt(0)
    s_mov_b64 exec, 1
    buffer_store_dwordx2 v[10:11], off, s[44:47], s11 offset:192 sc1
    s_mov_b64 exec, -1
    s_mov_b32 s53, 0
L_gs2:
    buffer_load_dwordx2 v[10:11], v15, s[44:47], s67 offen offset:192 sc1
    s_add_u32 s53, s53, 1
    s_waitcnt vmcnt(0)
    v_cmp_ne_u32 vcc, s68, v10
    v_cmp_ne_u32 s[62:63], s52, v11
    s_nop 3
    s_or_b64 s[62:63], s[62:63], vcc
    s_cbranch_scc0 L_r2
    s_cmp_gt_u32 s53, 0x200000
    s_cbranch_scc1 L_r2
    s_sleep 1
    s_branch L_gs2
.fill (13568 - (. - standalone__linear_kernel_rfa__prompt_kernel)) / 4, 4, 0xBF800000
.section .rodata,"a"
.p2align 6
.amdhsa_kernel standalone__linear_kernel_rfa__prompt_kernel
  .amdhsa_next_free_vgpr 168
  .amdhsa_next_free_sgpr 102
  .amdhsa_accum_offset 168
  .amdhsa_group_segment_fixed_size 0
  .amdhsa_kernarg_size 56
  .amdhsa_user_sgpr_count 2
  .amdhsa_user_sgpr_kernarg_segment_ptr 1
  .amdhsa_system_sgpr_workgroup_id_x 1
  .amdhsa_float_denorm_mode_32 3
.end_amdhsa_kernel
```
